```python
import torch

def _softmax(x, axis=-1):
    return torch.softmax(x, dim=axis)
def _gelu(x):
    return torch.nn.functional.gelu(x, approximate="tanh")
def _silu(x):
    return torch.nn.functional.silu(x)
def _sigmoid(x):
    return torch.sigmoid(x)
def _layernorm(x, axis=-1, eps=1e-5):
    m = x.mean(dim=axis, keepdim=True)
    v = x.var(dim=axis, keepdim=True, unbiased=False)
    return (x - m) / torch.sqrt(v + eps)
def _scatter_add(tgt, idx, src, axis=0):
    return tgt.clone().index_add_(axis, idx, src)
def _segment_sum(src, seg, n):
    out = torch.zeros((n,) + src.shape[1:], dtype=src.dtype)
    return out.index_add_(0, seg, src)
def _pad(x, pw):
    flat = tuple(v for pair in reversed(pw) for v in pair)
    return torch.nn.functional.pad(x, flat)

kernel_name = 'standalone__linear_kernel_rfa__decode'

def setup_inputs():

    _w = (lambda a: (lambda t: t.to(torch.bfloat16) if t.is_floating_point() else t)(torch.as_tensor(a)))
    B, H, Sq, Sk, D, M = 1, 32, 1, 4096, 128, 64
    return {
        "q": _w((lambda *s: torch.randn(*s, dtype=torch.bfloat16) * 0.2)(B, H, Sq, D)),
        "k": _w((lambda *s: torch.randn(*s, dtype=torch.bfloat16) * 1.6)(B, H, Sk, D)),
        "v": _w((lambda *s: torch.randn(*s, dtype=torch.bfloat16) * 1.6)(B, H, Sk, D)),
        "omega": _w((lambda *s: torch.randn(*s, dtype=torch.bfloat16) * 1.6)(M, D)),
    }

def reference(q, k, v, omega):
    d = q.shape[-1]
    m = omega.shape[0]
    scale = float(d) ** -0.25
    qs = q * scale
    ks = k * scale
    q_proj = torch.einsum("bhsd,md->bhsm", qs, omega)
    k_proj = torch.einsum("bhsd,md->bhsm", ks, omega)
    q_sq = 0.5 * torch.einsum("bhsd,bhsd->bhs", qs, qs)[..., None]
    k_sq = 0.5 * torch.einsum("bhsd,bhsd->bhs", ks, ks)[..., None]
    inv_sqrt_m = float(m) ** -0.5
    phi_q = torch.exp(q_proj - q_sq) * inv_sqrt_m + 1e-6
    phi_k = torch.exp(k_proj - k_sq) * inv_sqrt_m + 1e-6
    kv = torch.einsum("bhsm,bhsd->bhmd", phi_k, v)
    z  = torch.einsum("bhsm->bhm", phi_k)
    num = torch.einsum("bhqm,bhmd->bhqd", phi_q, kv)
    den = torch.einsum("bhqm,bhm->bhq", phi_q, z)[..., None] + 1e-6
    return num / den
```

```asm
; @launch grid=(256,1,1) block=(768,1,1) lds=156928
.amdgcn_target "amdgcn-amd-amdhsa--gfx950"
.text
.globl standalone__linear_kernel_rfa__decode_kernel
.p2align 8
.type standalone__linear_kernel_rfa__decode_kernel,@function
standalone__linear_kernel_rfa__decode_kernel:
    s_cmp_ge_u32 s2, 256
    s_cbranch_scc1 L_end
    s_load_dwordx2 s[16:17], s[0:1], 24
    s_load_dwordx2 s[8:9], s[0:1], 8
    s_load_dwordx2 s[20:21], s[0:1], 0
    s_load_dwordx2 s[12:13], s[0:1], 16
    s_load_dwordx2 s[24:25], s[0:1], 32
    s_load_dwordx2 s[28:29], s[0:1], 40
    s_load_dwordx2 s[32:33], s[0:1], 48
    v_lshrrev_b32 v5, 6, v0
    v_and_b32 v1, 63, v0
    v_readfirstlane_b32 s38, v5
    s_mov_b32 s10, 0x2000000
    s_mov_b32 s11, 0x00020000
    s_mov_b32 s14, 0x2000000
    s_mov_b32 s15, 0x00020000
    s_mov_b32 s18, 0x4000
    s_mov_b32 s19, 0x00020000
    s_mov_b32 s22, 0x2000
    s_mov_b32 s23, 0x00020000
    s_mov_b32 s26, 0x2000
    s_mov_b32 s27, 0x00020000
    s_mov_b32 s30, 0x100
    s_mov_b32 s31, 0x00020000
    s_mov_b32 s34, 0x800000
    s_mov_b32 s35, 0x00020000
    s_lshr_b32 s36, s2, 3
    s_and_b32 s37, s2, 7
    v_and_b32 v2, 15, v0
    v_lshrrev_b32 v3, 4, v1
    s_lshl_b32 s39, s36, 20
    s_lshl_b32 s40, s37, 17
    s_add_u32 s39, s39, s40
    s_lshl_b32 s47, s36, 8
    s_mov_b32 s46, 0xffff0000
    v_xor_b32 v4, v2, v3
    v_lshlrev_b32 v4, 4, v4
    s_cmp_ge_u32 s38, 8
    s_cbranch_scc1 L_vwave
    v_lshl_add_u32 v6, v3, 8, v4
    v_xor_b32 v7, 64, v6
    v_xor_b32 v8, 128, v6
    v_xor_b32 v9, 192, v6
    s_lshl_b32 s40, s38, 14
    s_add_u32 s62, s39, s40
    s_add_u32 s61, s40, 16384
    s_mov_b32 s63, s61
    s_lshl_b32 s40, s38, 12
    s_mov_b32 m0, s40
    s_waitcnt lgkmcnt(0)
    s_cmp_ge_u32 s38, 4
    s_cbranch_scc1 L_k_noom
    buffer_load_dwordx4 v6, s[16:19], s40 offen offset:0 lds
    buffer_load_dwordx4 v7, s[16:19], s40 offen offset:1024 lds
    buffer_load_dwordx4 v8, s[16:19], s40 offen offset:2048 lds
    buffer_load_dwordx4 v9, s[16:19], s40 offen offset:3072 lds
    s_cmp_lg_u32 s38, 0
    s_cbranch_scc1 L_k_noom
    s_mov_b32 m0, 151808
    v_lshlrev_b32 v5, 4, v1
    buffer_load_dwordx4 v5, s[20:23], s47 offen lds
L_k_noom:
    s_mov_b32 m0, s63
    s_add_u32 s63, s63, 4096
    buffer_load_dwordx4 v6, s[8:11], s62 offen offset:0 nt lds
    buffer_load_dwordx4 v7, s[8:11], s62 offen offset:1024 nt lds
    buffer_load_dwordx4 v8, s[8:11], s62 offen offset:2048 nt lds
    buffer_load_dwordx4 v9, s[8:11], s62 offen offset:3072 nt lds
    s_add_u32 s62, s62, 4096
    v_lshl_add_u32 v10, v2, 8, v4
    v_xor_b32 v11, 64, v10
    v_xor_b32 v12, 128, v10
    v_xor_b32 v13, 192, v10
    s_mov_b32 s42, 0x3e9837f0
    s_mov_b32 s43, 0x3e9837f0
    s_mov_b32 s44, 0x3fb8aa3b
    s_mov_b32 s45, 0x3fb8aa3b
    s_mov_b32 s58, 0x00003f80
    s_mov_b32 s59, 0x3f800000
    v_mov_b32 v20, 0xc0400000
    v_mov_b32 v21, 0xc0400000
    s_mov_b32 s55, 0
    s_mov_b64 s[56:57], 0xffff
    v_mov_b32 v18, 0
    s_waitcnt vmcnt(4)
    s_barrier
    ds_read_b128 v[32:35], v10 offset:0
    ds_read_b128 v[36:39], v11 offset:0
    ds_read_b128 v[40:43], v12 offset:0
    ds_read_b128 v[44:47], v13 offset:0
    ds_read_b128 v[48:51], v10 offset:4096
    ds_read_b128 v[52:55], v11 offset:4096
    ds_read_b128 v[56:59], v12 offset:4096
    ds_read_b128 v[60:63], v13 offset:4096
    ds_read_b128 v[64:67], v10 offset:8192
    ds_read_b128 v[68:71], v11 offset:8192
    ds_read_b128 v[72:75], v12 offset:8192
    ds_read_b128 v[76:79], v13 offset:8192
    ds_read_b128 v[80:83], v10 offset:12288
    ds_read_b128 v[84:87], v11 offset:12288
    ds_read_b128 v[88:91], v12 offset:12288
    ds_read_b128 v[92:95], v13 offset:12288
    v_add_u32 v10, s61, v10
    v_add_u32 v11, s61, v11
    v_add_u32 v12, s61, v12
    v_add_u32 v13, s61, v13
    s_mov_b32 m0, s63
    s_add_u32 s63, s63, 4096
    buffer_load_dwordx4 v6, s[8:11], s62 offen offset:0 nt lds
    buffer_load_dwordx4 v7, s[8:11], s62 offen offset:1024 nt lds
    buffer_load_dwordx4 v8, s[8:11], s62 offen offset:2048 nt lds
    buffer_load_dwordx4 v9, s[8:11], s62 offen offset:3072 nt lds
    s_add_u32 s62, s62, 4096
    s_mov_b32 m0, s63
    s_add_u32 s63, s63, 4096
    buffer_load_dwordx4 v6, s[8:11], s62 offen offset:0 nt lds
    buffer_load_dwordx4 v7, s[8:11], s62 offen offset:1024 nt lds
    buffer_load_dwordx4 v8, s[8:11], s62 offen offset:2048 nt lds
    buffer_load_dwordx4 v9, s[8:11], s62 offen offset:3072 nt lds
    s_add_u32 s62, s62, 4096
    s_mov_b32 m0, s63
    s_add_u32 s63, s63, 4096
    buffer_load_dwordx4 v6, s[8:11], s62 offen offset:0 nt lds
    buffer_load_dwordx4 v7, s[8:11], s62 offen offset:1024 nt lds
    buffer_load_dwordx4 v8, s[8:11], s62 offen offset:2048 nt lds
    buffer_load_dwordx4 v9, s[8:11], s62 offen offset:3072 nt lds
    s_add_u32 s62, s62, 4096
L_tile:
    s_cmp_ge_u32 s55, 2
    s_cbranch_scc1 L_w23
    s_cmp_eq_u32 s55, 1
    s_cbranch_scc1 L_w1
    s_waitcnt vmcnt(12)
    s_branch L_go
L_w1:
    s_waitcnt vmcnt(8)
    s_branch L_go
L_w23:
    s_cmp_eq_u32 s55, 3
    s_cbranch_scc1 L_w0
    s_waitcnt vmcnt(4)
    s_branch L_go
L_w0:
    s_waitcnt vmcnt(0)
L_go:
    ds_read_b128 v[96:99], v10
    ds_read_b128 v[100:103], v11
    ds_read_b128 v[104:107], v12
    ds_read_b128 v[108:111], v13
    v_add_u32 v10, 4096, v10
    v_add_u32 v11, 4096, v11
    v_add_u32 v12, 4096, v12
    v_add_u32 v13, 4096, v13
    s_waitcnt lgkmcnt(0)
    v_lshlrev_b32 v144, 16, v96
    v_lshlrev_b32 v146, 16, v97
    v_lshlrev_b32 v148, 16, v98
    v_lshlrev_b32 v150, 16, v99
    v_and_b32 v145, s46, v96
    v_and_b32 v147, s46, v97
    v_and_b32 v149, s46, v98
    v_and_b32 v151, s46, v99
    v_pk_mul_f32 v[144:145], v[144:145], s[42:43]
    v_pk_mul_f32 v[146:147], v[146:147], s[42:43]
    v_pk_mul_f32 v[148:149], v[148:149], s[42:43]
    v_pk_mul_f32 v[150:151], v[150:151], s[42:43]
    v_cvt_pk_bf16_f32 v96, v144, v145
    v_cvt_pk_bf16_f32 v97, v146, v147
    v_cvt_pk_bf16_f32 v98, v148, v149
    v_cvt_pk_bf16_f32 v99, v150, v151
    v_dot2_f32_bf16 v17, v96, v96, 0
    v_dot2c_f32_bf16 v17, v97, v97
    v_dot2c_f32_bf16 v17, v98, v98
    v_dot2c_f32_bf16 v17, v99, v99
    v_lshlrev_b32 v152, 16, v100
    v_lshlrev_b32 v154, 16, v101
    v_lshlrev_b32 v156, 16, v102
    v_lshlrev_b32 v158, 16, v103
    v_and_b32 v153, s46, v100
    v_and_b32 v155, s46, v101
    v_and_b32 v157, s46, v102
    v_and_b32 v159, s46, v103
    v_pk_mul_f32 v[152:153], v[152:153], s[42:43]
    v_pk_mul_f32 v[154:155], v[154:155], s[42:43]
    v_pk_mul_f32 v[156:157], v[156:157], s[42:43]
    v_pk_mul_f32 v[158:159], v[158:159], s[42:43]
    v_cvt_pk_bf16_f32 v100, v152, v153
    v_cvt_pk_bf16_f32 v101, v154, v155
    v_cvt_pk_bf16_f32 v102, v156, v157
    v_cvt_pk_bf16_f32 v103, v158, v159
    v_dot2c_f32_bf16 v17, v100, v100
    v_dot2c_f32_bf16 v17, v101, v101
    v_dot2c_f32_bf16 v17, v102, v102
    v_dot2c_f32_bf16 v17, v103, v103
    v_lshlrev_b32 v160, 16, v104
    v_lshlrev_b32 v162, 16, v105
    v_lshlrev_b32 v164, 16, v106
    v_lshlrev_b32 v166, 16, v107
    v_and_b32 v161, s46, v104
    v_and_b32 v163, s46, v105
    v_and_b32 v165, s46, v106
    v_and_b32 v167, s46, v107
    v_pk_mul_f32 v[160:161], v[160:161], s[42:43]
    v_pk_mul_f32 v[162:163], v[162:163], s[42:43]
    v_pk_mul_f32 v[164:165], v[164:165], s[42:43]
    v_pk_mul_f32 v[166:167], v[166:167], s[42:43]
    v_cvt_pk_bf16_f32 v104, v160, v161
    v_cvt_pk_bf16_f32 v105, v162, v163
    v_cvt_pk_bf16_f32 v106, v164, v165
    v_cvt_pk_bf16_f32 v107, v166, v167
    v_dot2c_f32_bf16 v17, v104, v104
    v_dot2c_f32_bf16 v17, v105, v105
    v_dot2c_f32_bf16 v17, v106, v106
    v_dot2c_f32_bf16 v17, v107, v107
    v_lshlrev_b32 v144, 16, v108
    v_lshlrev_b32 v146, 16, v109
    v_lshlrev_b32 v148, 16, v110
    v_lshlrev_b32 v150, 16, v111
    v_and_b32 v145, s46, v108
    v_and_b32 v147, s46, v109
    v_and_b32 v149, s46, v110
    v_and_b32 v151, s46, v111
    v_pk_mul_f32 v[144:145], v[144:145], s[42:43]
    v_pk_mul_f32 v[146:147], v[146:147], s[42:43]
    v_pk_mul_f32 v[148:149], v[148:149], s[42:43]
    v_pk_mul_f32 v[150:151], v[150:151], s[42:43]
    v_cvt_pk_bf16_f32 v108, v144, v145
    v_cvt_pk_bf16_f32 v109, v146, v147
    v_cvt_pk_bf16_f32 v110, v148, v149
    v_cvt_pk_bf16_f32 v111, v150, v151
    v_dot2c_f32_bf16 v17, v108, v108
    v_dot2c_f32_bf16 v17, v109, v109
    v_dot2c_f32_bf16 v17, v110, v110
    v_dot2c_f32_bf16 v17, v111, v111
    v_mfma_f32_16x16x32_bf16 v[112:115], v[32:35], v[96:99], 0
    v_mfma_f32_16x16x32_bf16 v[116:119], v[48:51], v[96:99], 0
    v_mfma_f32_16x16x32_bf16 v[120:123], v[64:67], v[96:99], 0
    v_mfma_f32_16x16x32_bf16 v[124:127], v[80:83], v[96:99], 0
    v_mov_b32 v5, v17
    v_mfma_f32_16x16x32_bf16 v[112:115], v[36:39], v[100:103], v[112:115]
    v_mfma_f32_16x16x32_bf16 v[116:119], v[52:55], v[100:103], v[116:119]
    v_permlane32_swap_b32 v17, v5
    v_mfma_f32_16x16x32_bf16 v[120:123], v[68:71], v[100:103], v[120:123]
    v_add_f32 v17, v17, v5
    v_mfma_f32_16x16x32_bf16 v[124:127], v[84:87], v[100:103], v[124:127]
    v_mov_b32 v5, v17
    v_mfma_f32_16x16x32_bf16 v[112:115], v[40:43], v[104:107], v[112:115]
    v_mfma_f32_16x16x32_bf16 v[116:119], v[56:59], v[104:107], v[116:119]
    v_permlane16_swap_b32 v17, v5
    v_mfma_f32_16x16x32_bf16 v[120:123], v[72:75], v[104:107], v[120:123]
    v_add_f32 v17, v17, v5
    v_mfma_f32_16x16x32_bf16 v[124:127], v[88:91], v[104:107], v[124:127]
    v_cvt_pk_bf16_f32 v17, v17, v17
    v_mfma_f32_16x16x32_bf16 v[112:115], v[44:47], v[108:111], v[112:115]
    v_and_b32 v17, s46, v17
    v_mfma_f32_16x16x32_bf16 v[116:119], v[60:63], v[108:111], v[116:119]
    v_mul_f32 v16, -0.5, v17
    v_mfma_f32_16x16x32_bf16 v[120:123], v[76:79], v[108:111], v[120:123]
    v_mfma_f32_16x16x32_bf16 v[124:127], v[92:95], v[108:111], v[124:127]
    s_nop 4
    v_cvt_pk_bf16_f32 v112, v112, v113
    v_cvt_pk_bf16_f32 v114, v114, v115
    v_cvt_pk_bf16_f32 v116, v116, v117
    v_cvt_pk_bf16_f32 v118, v118, v119
    v_cvt_pk_bf16_f32 v120, v120, v121
    v_cvt_pk_bf16_f32 v122, v122, v123
    v_cvt_pk_bf16_f32 v124, v124, v125
    v_cvt_pk_bf16_f32 v126, v126, v127
    v_dot2_f32_bf16 v113, v112, s59, v16
    v_dot2_f32_bf16 v115, v114, s59, v16
    v_dot2_f32_bf16 v117, v116, s59, v16
    v_dot2_f32_bf16 v119, v118, s59, v16
    v_dot2_f32_bf16 v121, v120, s59, v16
    v_dot2_f32_bf16 v123, v122, s59, v16
    v_dot2_f32_bf16 v125, v124, s59, v16
    v_dot2_f32_bf16 v127, v126, s59, v16
    v_dot2_f32_bf16 v112, v112, s58, v16
    v_dot2_f32_bf16 v114, v114, s58, v16
    v_dot2_f32_bf16 v116, v116, s58, v16
    v_dot2_f32_bf16 v118, v118, s58, v16
    v_dot2_f32_bf16 v120, v120, s58, v16
    v_dot2_f32_bf16 v122, v122, s58, v16
    v_dot2_f32_bf16 v124, v124, s58, v16
    v_dot2_f32_bf16 v126, v126, s58, v16
    v_cvt_pk_bf16_f32 v112, v112, v113
    v_cvt_pk_bf16_f32 v114, v114, v115
    v_cvt_pk_bf16_f32 v116, v116, v117
    v_cvt_pk_bf16_f32 v118, v118, v119
    v_cvt_pk_bf16_f32 v120, v120, v121
    v_cvt_pk_bf16_f32 v122, v122, v123
    v_cvt_pk_bf16_f32 v124, v124, v125
    v_cvt_pk_bf16_f32 v126, v126, v127
    v_and_b32 v113, s46, v112
    v_lshlrev_b32 v112, 16, v112
    v_and_b32 v115, s46, v114
    v_lshlrev_b32 v114, 16, v114
    v_and_b32 v117, s46, v116
    v_lshlrev_b32 v116, 16, v116
    v_and_b32 v119, s46, v118
    v_lshlrev_b32 v118, 16, v118
    v_and_b32 v121, s46, v120
    v_lshlrev_b32 v120, 16, v120
    v_and_b32 v123, s46, v122
    v_lshlrev_b32 v122, 16, v122
    v_and_b32 v125, s46, v124
    v_lshlrev_b32 v124, 16, v124
    v_and_b32 v127, s46, v126
    v_lshlrev_b32 v126, 16, v126
    v_pk_fma_f32 v[112:113], v[112:113], s[44:45], v[20:21]
    v_pk_fma_f32 v[114:115], v[114:115], s[44:45], v[20:21]
    v_pk_fma_f32 v[116:117], v[116:117], s[44:45], v[20:21]
    v_pk_fma_f32 v[118:119], v[118:119], s[44:45], v[20:21]
    v_pk_fma_f32 v[120:121], v[120:121], s[44:45], v[20:21]
    v_pk_fma_f32 v[122:123], v[122:123], s[44:45], v[20:21]
    v_pk_fma_f32 v[124:125], v[124:125], s[44:45], v[20:21]
    v_pk_fma_f32 v[126:127], v[126:127], s[44:45], v[20:21]
    v_exp_f32 v112, v112
    v_exp_f32 v113, v113
    v_exp_f32 v114, v114
    v_exp_f32 v115, v115
    v_exp_f32 v116, v116
    v_exp_f32 v117, v117
    v_exp_f32 v118, v118
    v_exp_f32 v119, v119
    v_exp_f32 v120, v120
    v_exp_f32 v121, v121
    v_exp_f32 v122, v122
    v_exp_f32 v123, v123
    v_exp_f32 v124, v124
    v_exp_f32 v125, v125
    v_exp_f32 v126, v126
    v_exp_f32 v127, v127
    v_cvt_pk_bf16_f32 v136, v112, v113
    v_cvt_pk_bf16_f32 v137, v114, v115
    v_cvt_pk_bf16_f32 v138, v116, v117
    v_cvt_pk_bf16_f32 v139, v118, v119
    v_cvt_pk_bf16_f32 v140, v120, v121
    v_cvt_pk_bf16_f32 v141, v122, v123
    v_cvt_pk_bf16_f32 v142, v124, v125
    v_cvt_pk_bf16_f32 v143, v126, v127
    s_cmp_lg_u32 s55, 0
    s_cbranch_scc1 L_havepq
    v_mov_b32 v144, 149536
L_pqwait:
    ds_read_b32 v145, v144
    s_waitcnt lgkmcnt(0)
    v_readfirstlane_b32 s40, v145
    s_nop 3
    s_cmp_lt_u32 s40, 4
    s_cbranch_scc1 L_pqwait
    v_lshlrev_b32 v144, 5, v3
    v_add_u32 v144, 149568, v144
    ds_read_b128 v[128:131], v144
    ds_read_b128 v[132:135], v144 offset:16
    v_mov_b32 v148, 0x3f803f80
    v_mov_b32 v149, 0x3f803f80
    v_mov_b32 v150, 0x3f803f80
    v_mov_b32 v151, 0x3f803f80
    v_mov_b32 v144, 0x358637bd
    s_waitcnt lgkmcnt(0)
    v_mfma_f32_16x16x32_bf16 v[28:31], v[128:131], v[148:151], 0
    v_mfma_f32_16x16x32_bf16 v[28:31], v[132:135], v[148:151], v[28:31]
    s_nop 7
    v_mul_f32 v24, v144, v28
    v_mul_f32 v25, v144, v29
    v_mul_f32 v26, v144, v30
    v_mul_f32 v27, v144, v31
    s_nop 1
L_havepq:
    v_mfma_f32_16x16x32_bf16 v[28:31], v[128:131], v[136:139], v[24:27]
    v_mfma_f32_16x16x32_bf16 v[28:31], v[132:135], v[140:143], v[28:31]
    s_add_u32 s55, s55, 1
    s_nop 6
    v_cndmask_b32 v18, v18, v28, s[56:57]
    s_lshl_b64 s[56:57], s[56:57], 16
    s_cmp_lt_u32 s55, 4
    s_cbranch_scc1 L_tile
    v_cvt_pk_bf16_f32 v5, v18, v18
    s_lshl_b32 s40, s38, 8
    v_and_b32 v5, s46, v5
    s_add_u32 s40, s40, 147456
    v_sub_f32 v19, v18, v5
    v_lshlrev_b32 v144, 2, v1
    v_cvt_pk_bf16_f32 v19, v19, v5
    v_add_u32 v144, s40, v144
    ds_write_b32 v144, v19
    v_add_f32_dpp v146, v18, v18 quad_perm:[1,0,3,2] row_mask:0xf bank_mask:0xf
    s_nop 1
    v_add_f32_dpp v146, v146, v146 quad_perm:[2,3,0,1] row_mask:0xf bank_mask:0xf
    s_nop 1
    v_add_f32_dpp v146, v146, v146 row_half_mirror row_mask:0xf bank_mask:0xf
    s_nop 1
    v_add_f32_dpp v146, v146, v146 row_mirror row_mask:0xf bank_mask:0xf
    v_mov_b32 v147, v146
    s_nop 1
    v_permlane32_swap_b32 v146, v147
    s_nop 0
    v_add_f32 v146, v146, v147
    v_mov_b32 v147, v146
    s_nop 1
    v_permlane16_swap_b32 v146, v147
    s_nop 0
    v_add_f32 v146, v146, v147
    s_lshl_b32 s40, s38, 2
    s_add_u32 s40, s40, 149504
    v_mov_b32 v147, s40
    s_mov_b64 exec, 1
    ds_write_b32 v147, v146
    s_mov_b64 exec, -1
    s_waitcnt lgkmcnt(0)
    s_barrier
    v_mov_b32 v146, 149552
    v_mov_b32 v147, 149504
    ds_read_b64 v[148:149], v146
    ds_read_b128 v[32:35], v147
    ds_read_b128 v[36:39], v147 offset:16
    s_cmp_eq_u32 s37, 5
    s_cbranch_scc1 L_k_cons
    s_cmp_lg_u32 s38, 0
    s_cbranch_scc1 L_k_exit
    s_lshl_b32 s40, s36, 7
    s_lshl_b32 s41, s37, 4
    s_add_u32 s40, s40, s41
    s_add_u32 s40, s40, 524288
    v_mov_b32 v5, 0
    s_waitcnt lgkmcnt(0)
    v_add_f32 v32, v32, v33
    v_add_f32 v32, v32, v34
    v_add_f32 v32, v32, v35
    v_add_f32 v32, v32, v36
    v_add_f32 v32, v32, v37
    v_add_f32 v32, v32, v38
    v_add_f32 v32, v32, v39
    v_mov_b32 v33, 0
    v_mov_b32 v34, v148
    v_mov_b32 v35, v149
    s_mov_b64 exec, 1
    s_add_u32 s40, s40, 1048576
    buffer_store_dwordx4 v[32:35], v5, s[32:35], s40 offen sc1
    s_mov_b64 exec, -1
L_k_exit:
    s_endpgm
L_k_cons:
    s_waitcnt lgkmcnt(0)
    v_readfirstlane_b32 s48, v148
    v_readfirstlane_b32 s49, v149
    s_cmp_eq_u32 s38, 7
    s_cbranch_scc1 L_k_den
    s_cmp_ge_u32 s38, 5
    s_cselect_b32 s40, 1, 0
    s_add_u32 s40, s40, s38
    s_lshl_b32 s40, s40, 10
    s_lshl_b32 s54, s36, 13
    s_add_u32 s54, s54, s40
    s_add_u32 s41, s54, 1048576
    v_lshlrev_b32 v5, 4, v1
    s_lshl_b32 s40, s38, 9
    s_add_u32 s40, s40, 152832
    v_lshlrev_b32 v146, 3, v1
    v_add_u32 v146, s40, v146
L_gloop:
    buffer_load_dwordx4 v[44:47], v5, s[32:35], s41 offen sc1
    s_waitcnt vmcnt(0)
    v_xor_b32 v48, s48, v46
    v_xor_b32 v49, s49, v47
    v_or_b32 v48, v48, v49
    v_cmp_ne_u32 vcc, 0, v48
    s_nop 4
    s_cbranch_vccnz L_gloop
    ds_write_b64 v146, v[44:45]
    s_branch L_k_fin
L_k_den:
    v_add_f32 v32, v32, v33
    v_add_f32 v32, v32, v34
    v_add_f32 v32, v32, v35
    v_add_f32 v32, v32, v36
    v_add_f32 v32, v32, v37
    v_add_f32 v32, v32, v38
    v_add_f32 v32, v32, v39
    v_and_b32 v146, 7, v1
    v_lshlrev_b32 v5, 4, v146
    s_lshl_b32 s54, s36, 7
    s_add_u32 s54, s54, 524288
    s_add_u32 s41, s54, 1048576
    v_cmp_eq_u32 s[52:53], 5, v146
L_dloop:
    buffer_load_dwordx4 v[44:47], v5, s[32:35], s41 offen sc1
    s_waitcnt vmcnt(0)
    v_xor_b32 v48, s48, v46
    v_xor_b32 v49, s49, v47
    v_or_b32 v48, v48, v49
    v_cmp_eq_u32 vcc, 0, v48
    s_nop 1
    s_or_b64 vcc, vcc, s[52:53]
    s_cmp_eq_u64 vcc, -1
    s_cbranch_scc0 L_dloop
    v_cndmask_b32 v44, v44, v32, s[52:53]
    s_nop 1
    v_add_f32_dpp v44, v44, v44 quad_perm:[1,0,3,2] row_mask:0xf bank_mask:0xf
    s_nop 1
    v_add_f32_dpp v44, v44, v44 quad_perm:[2,3,0,1] row_mask:0xf bank_mask:0xf
    s_nop 1
    v_add_f32_dpp v44, v44, v44 row_half_mirror row_mask:0xf bank_mask:0xf
    v_cvt_pk_bf16_f32 v44, v44, v44
    v_and_b32 v44, s46, v44
    v_add_f32 v44, 0x358637bd, v44
    v_cvt_pk_bf16_f32 v44, v44, v44
    v_and_b32 v44, s46, v44
    v_rcp_f32 v44, v44
    v_mov_b32 v45, 149560
    s_mov_b64 exec, 1
    ds_write_b32 v45, v44
    s_mov_b64 exec, -1
L_k_fin:
    s_waitcnt lgkmcnt(0)
    s_barrier
    s_endpgm
L_vwave:
    s_sub_u32 s38, s38, 8
    s_lshl_b32 s40, s38, 15
    s_add_u32 s39, s39, s40
    v_lshlrev_b32 v6, 4, v1
    v_lshlrev_b32 v5, 4, v3
    v_mov_b32 v160, 149536
    v_mov_b32 v161, 0
    ds_write_b32 v160, v161
    s_lshl_b32 s40, s38, 12
    v_lshl_add_u32 v164, v2, 8, v4
    v_add_u32 v164, s40, v164
    v_xor_b32 v165, 64, v164
    v_xor_b32 v166, 128, v164
    v_xor_b32 v167, 192, v164
    s_mov_b32 s42, 0x3e9837f0
    s_mov_b32 s43, 0x3e9837f0
    s_mov_b32 s44, 0x3fb8aa3b
    s_mov_b32 s45, 0x3fb8aa3b
    s_mov_b32 s58, 0x00003f80
    s_mov_b32 s59, 0x3f800000
    v_mov_b32 v98, 0xc0400000
    v_mov_b32 v99, 0xc0400000
    s_waitcnt lgkmcnt(0)
    v_add_u32 v5, 151808, v5
    s_barrier
    s_setprio 3
    ds_read_b128 v[48:51], v5 offset:0
    ds_read_b128 v[52:55], v5 offset:64
    ds_read_b128 v[56:59], v5 offset:128
    ds_read_b128 v[60:63], v5 offset:192
    ds_read_b128 v[32:35], v164 offset:0
    ds_read_b128 v[36:39], v165 offset:0
    ds_read_b128 v[40:43], v166 offset:0
    ds_read_b128 v[44:47], v167 offset:0
    s_waitcnt lgkmcnt(4)
    v_lshlrev_b32 v72, 16, v48
    v_lshlrev_b32 v74, 16, v49
    v_lshlrev_b32 v76, 16, v50
    v_lshlrev_b32 v78, 16, v51
    v_and_b32 v73, s46, v48
    v_and_b32 v75, s46, v49
    v_and_b32 v77, s46, v50
    v_and_b32 v79, s46, v51
    v_pk_mul_f32 v[72:73], v[72:73], s[42:43]
    v_pk_mul_f32 v[74:75], v[74:75], s[42:43]
    v_pk_mul_f32 v[76:77], v[76:77], s[42:43]
    v_pk_mul_f32 v[78:79], v[78:79], s[42:43]
    v_cvt_pk_bf16_f32 v48, v72, v73
    v_cvt_pk_bf16_f32 v49, v74, v75
    v_cvt_pk_bf16_f32 v50, v76, v77
    v_cvt_pk_bf16_f32 v51, v78, v79
    v_dot2_f32_bf16 v97, v48, v48, 0
    v_dot2c_f32_bf16 v97, v49, v49
    v_dot2c_f32_bf16 v97, v50, v50
    v_dot2c_f32_bf16 v97, v51, v51
    v_lshlrev_b32 v80, 16, v52
    v_lshlrev_b32 v82, 16, v53
    v_lshlrev_b32 v84, 16, v54
    v_lshlrev_b32 v86, 16, v55
    v_and_b32 v81, s46, v52
    v_and_b32 v83, s46, v53
    v_and_b32 v85, s46, v54
    v_and_b32 v87, s46, v55
    v_pk_mul_f32 v[80:81], v[80:81], s[42:43]
    v_pk_mul_f32 v[82:83], v[82:83], s[42:43]
    v_pk_mul_f32 v[84:85], v[84:85], s[42:43]
    v_pk_mul_f32 v[86:87], v[86:87], s[42:43]
    v_cvt_pk_bf16_f32 v52, v80, v81
    v_cvt_pk_bf16_f32 v53, v82, v83
    v_cvt_pk_bf16_f32 v54, v84, v85
    v_cvt_pk_bf16_f32 v55, v86, v87
    v_dot2c_f32_bf16 v97, v52, v52
    v_dot2c_f32_bf16 v97, v53, v53
    v_dot2c_f32_bf16 v97, v54, v54
    v_dot2c_f32_bf16 v97, v55, v55
    v_lshlrev_b32 v88, 16, v56
    v_lshlrev_b32 v90, 16, v57
    v_lshlrev_b32 v92, 16, v58
    v_lshlrev_b32 v94, 16, v59
    v_and_b32 v89, s46, v56
    v_and_b32 v91, s46, v57
    v_and_b32 v93, s46, v58
    v_and_b32 v95, s46, v59
    v_pk_mul_f32 v[88:89], v[88:89], s[42:43]
    v_pk_mul_f32 v[90:91], v[90:91], s[42:43]
    v_pk_mul_f32 v[92:93], v[92:93], s[42:43]
    v_pk_mul_f32 v[94:95], v[94:95], s[42:43]
    v_cvt_pk_bf16_f32 v56, v88, v89
    v_cvt_pk_bf16_f32 v57, v90, v91
    v_cvt_pk_bf16_f32 v58, v92, v93
    v_cvt_pk_bf16_f32 v59, v94, v95
    v_dot2c_f32_bf16 v97, v56, v56
    v_dot2c_f32_bf16 v97, v57, v57
    v_dot2c_f32_bf16 v97, v58, v58
    v_dot2c_f32_bf16 v97, v59, v59
    v_lshlrev_b32 v72, 16, v60
    v_lshlrev_b32 v74, 16, v61
    v_lshlrev_b32 v76, 16, v62
    v_lshlrev_b32 v78, 16, v63
    v_and_b32 v73, s46, v60
    v_and_b32 v75, s46, v61
    v_and_b32 v77, s46, v62
    v_and_b32 v79, s46, v63
    v_pk_mul_f32 v[72:73], v[72:73], s[42:43]
    v_pk_mul_f32 v[74:75], v[74:75], s[42:43]
    v_pk_mul_f32 v[76:77], v[76:77], s[42:43]
    v_pk_mul_f32 v[78:79], v[78:79], s[42:43]
    v_cvt_pk_bf16_f32 v60, v72, v73
    v_cvt_pk_bf16_f32 v61, v74, v75
    v_cvt_pk_bf16_f32 v62, v76, v77
    v_cvt_pk_bf16_f32 v63, v78, v79
    v_dot2c_f32_bf16 v97, v60, v60
    v_dot2c_f32_bf16 v97, v61, v61
    v_dot2c_f32_bf16 v97, v62, v62
    v_dot2c_f32_bf16 v97, v63, v63
    s_waitcnt lgkmcnt(0)
    v_mfma_f32_16x16x32_bf16 v[64:67], v[32:35], v[48:51], 0
    v_mfma_f32_16x16x32_bf16 v[64:67], v[36:39], v[52:55], v[64:67]
    v_mfma_f32_16x16x32_bf16 v[64:67], v[40:43], v[56:59], v[64:67]
    v_mfma_f32_16x16x32_bf16 v[64:67], v[44:47], v[60:63], v[64:67]
    v_mov_b32 v5, v97
    s_nop 1
    v_permlane32_swap_b32 v97, v5
    s_nop 0
    v_add_f32 v97, v97, v5
    v_mov_b32 v5, v97
    s_nop 1
    v_permlane16_swap_b32 v97, v5
    s_nop 0
    v_add_f32 v97, v97, v5
    v_cvt_pk_bf16_f32 v97, v97, v97
    v_and_b32 v97, s46, v97
    v_mul_f32 v96, -0.5, v97
    s_nop 1
    v_cvt_pk_bf16_f32 v64, v64, v65
    v_cvt_pk_bf16_f32 v66, v66, v67
    s_nop 1
    v_dot2_f32_bf16 v65, v64, s59, v96
    v_dot2_f32_bf16 v67, v66, s59, v96
    v_dot2_f32_bf16 v64, v64, s58, v96
    v_dot2_f32_bf16 v66, v66, s58, v96
    s_nop 3
    v_cvt_pk_bf16_f32 v64, v64, v65
    v_cvt_pk_bf16_f32 v66, v66, v67
    v_and_b32 v65, s46, v64
    v_lshlrev_b32 v64, 16, v64
    v_and_b32 v67, s46, v66
    v_lshlrev_b32 v66, 16, v66
    v_pk_fma_f32 v[64:65], v[64:65], s[44:45], v[98:99]
    v_pk_fma_f32 v[66:67], v[66:67], s[44:45], v[98:99]
    v_exp_f32 v64, v64
    v_exp_f32 v65, v65
    v_exp_f32 v66, v66
    v_exp_f32 v67, v67
    v_mov_b32 v72, 0x358637bd
    v_mov_b32 v73, 0x358637bd
    v_pk_add_f32 v[64:65], v[64:65], v[72:73]
    v_pk_add_f32 v[66:67], v[66:67], v[72:73]
    v_cvt_pk_bf16_f32 v74, v64, v65
    v_cvt_pk_bf16_f32 v75, v66, v67
    s_lshl_b32 s40, s38, 3
    s_add_u32 s40, s40, 149568
    v_lshlrev_b32 v5, 5, v3
    v_add_u32 v5, s40, v5
    v_mov_b32 v161, 1
    s_mov_b32 s50, 0x00010001
    s_mov_b32 s51, 0x00010001
    s_mov_b64 exec, s[50:51]
    ds_write_b64 v5, v[74:75]
    s_mov_b64 exec, 1
    ds_add_u32 v160, v161
    s_cmp_lg_u32 s38, 0
    s_cbranch_scc1 L_v_nononce
    s_memrealtime s[48:49]
    v_mov_b32 v30, 0
    v_mov_b32 v31, 0
    s_lshl_b32 s40, s36, 3
    v_mov_b32 v5, s40
    s_waitcnt lgkmcnt(0)
    s_or_b32 s48, s48, 1
    v_mov_b32 v28, s48
    v_mov_b32 v29, s49
    buffer_atomic_cmpswap_x2 v[28:31], v5, s[28:31], 0 offen sc0
L_v_nononce:
    s_mov_b64 exec, -1
    s_setprio 0
    s_add_u32 s41, s39, 0
    buffer_load_dwordx4 v[32:35], v6, s[12:15], s41 offen offset:0 nt
    buffer_load_dwordx4 v[36:39], v6, s[12:15], s41 offen offset:1024 nt
    buffer_load_dwordx4 v[40:43], v6, s[12:15], s41 offen offset:2048 nt
    buffer_load_dwordx4 v[44:47], v6, s[12:15], s41 offen offset:3072 nt
    s_add_u32 s41, s39, 4096
    buffer_load_dwordx4 v[48:51], v6, s[12:15], s41 offen offset:0 nt
    buffer_load_dwordx4 v[52:55], v6, s[12:15], s41 offen offset:1024 nt
    buffer_load_dwordx4 v[56:59], v6, s[12:15], s41 offen offset:2048 nt
    buffer_load_dwordx4 v[60:63], v6, s[12:15], s41 offen offset:3072 nt
    s_add_u32 s41, s39, 8192
    buffer_load_dwordx4 v[64:67], v6, s[12:15], s41 offen offset:0 nt
    buffer_load_dwordx4 v[68:71], v6, s[12:15], s41 offen offset:1024 nt
    buffer_load_dwordx4 v[72:75], v6, s[12:15], s41 offen offset:2048 nt
    buffer_load_dwordx4 v[76:79], v6, s[12:15], s41 offen offset:3072 nt
    s_add_u32 s41, s39, 12288
    buffer_load_dwordx4 v[80:83], v6, s[12:15], s41 offen offset:0 nt
    buffer_load_dwordx4 v[84:87], v6, s[12:15], s41 offen offset:1024 nt
    buffer_load_dwordx4 v[88:91], v6, s[12:15], s41 offen offset:2048 nt
    buffer_load_dwordx4 v[92:95], v6, s[12:15], s41 offen offset:3072 nt
    s_add_u32 s41, s39, 16384
    buffer_load_dwordx4 v[96:99], v6, s[12:15], s41 offen offset:0 nt
    buffer_load_dwordx4 v[100:103], v6, s[12:15], s41 offen offset:1024 nt
    buffer_load_dwordx4 v[104:107], v6, s[12:15], s41 offen offset:2048 nt
    buffer_load_dwordx4 v[108:111], v6, s[12:15], s41 offen offset:3072 nt
    s_add_u32 s41, s39, 20480
    buffer_load_dwordx4 v[112:115], v6, s[12:15], s41 offen offset:0 nt
    buffer_load_dwordx4 v[116:119], v6, s[12:15], s41 offen offset:1024 nt
    buffer_load_dwordx4 v[120:123], v6, s[12:15], s41 offen offset:2048 nt
    buffer_load_dwordx4 v[124:127], v6, s[12:15], s41 offen offset:3072 nt
    s_add_u32 s41, s39, 24576
    buffer_load_dwordx4 v[128:131], v6, s[12:15], s41 offen offset:0 nt
    buffer_load_dwordx4 v[132:135], v6, s[12:15], s41 offen offset:1024 nt
    buffer_load_dwordx4 v[136:139], v6, s[12:15], s41 offen offset:2048 nt
    buffer_load_dwordx4 v[140:143], v6, s[12:15], s41 offen offset:3072 nt
    s_add_u32 s41, s39, 28672
    buffer_load_dwordx4 v[144:147], v6, s[12:15], s41 offen offset:0 nt
    buffer_load_dwordx4 v[148:151], v6, s[12:15], s41 offen offset:1024 nt
    buffer_load_dwordx4 v[152:155], v6, s[12:15], s41 offen offset:2048 nt
    buffer_load_dwordx4 v[156:159], v6, s[12:15], s41 offen offset:3072 nt
    v_mov_b32 v160, 0x0302
    v_mov_b32 v161, 0x0100
    v_cmp_gt_u32 vcc, 8, v2
    s_nop 1
    v_cndmask_b32 v160, v161, v160, vcc
    v_lshlrev_b32 v161, 16, v160
    v_or_b32 v161, 0x0c0c, v161
    v_or_b32 v160, 0x0c0c0000, v160
    v_and_b32 v162, 1, v2
    v_cmp_eq_u32 vcc, 1, v162
    s_nop 1
    v_cndmask_b32 v160, v160, v161, vcc
    v_bfe_u32 v162, v2, 1, 2
    v_mov_b32 v161, 0x0c0c0c0c
    v_cmp_eq_u32 vcc, 0, v162
    s_nop 1
    v_cndmask_b32 v8, v161, v160, vcc
    v_cmp_eq_u32 vcc, 1, v162
    s_nop 1
    v_cndmask_b32 v9, v161, v160, vcc
    v_cmp_eq_u32 vcc, 2, v162
    s_nop 1
    v_cndmask_b32 v10, v161, v160, vcc
    v_cmp_eq_u32 vcc, 3, v162
    s_nop 1
    v_cndmask_b32 v11, v161, v160, vcc
    s_lshl_b32 s40, s38, 9
    s_add_u32 s40, s40, 147456
    v_lshl_add_u32 v162, v2, 2, v3
    v_lshlrev_b32 v162, 2, v162
    v_add_u32 v162, s40, v162
    s_lshl_b32 s40, s38, 9
    s_add_u32 s40, s40, 149760
    v_lshlrev_b32 v5, 3, v1
    v_add_u32 v5, s40, v5
    s_cmp_lg_u32 s38, 0
    s_cbranch_scc1 L_v_b2
    s_waitcnt vmcnt(32)
    v_readfirstlane_b32 s40, v28
    v_readfirstlane_b32 s41, v29
    s_nop 3
    s_or_b32 s52, s40, s41
    s_cmp_eq_u32 s52, 0
    s_cselect_b32 s48, s48, s40
    s_cselect_b32 s49, s49, s41
    v_mov_b32 v160, 149552
    v_mov_b32 v28, s48
    v_mov_b32 v29, s49
    ds_write_b64 v160, v[28:29]
    s_waitcnt lgkmcnt(0)
L_v_b2:
    s_barrier
    s_setprio 3
    ds_read_b32 v12, v162
    ds_read_b32 v13, v162 offset:256
    s_waitcnt lgkmcnt(0)
    s_mov_b32 s3, 0
L_vphase:
    v_mov_b32_dpp v14, v12 row_newbcast:0 row_mask:0xf bank_mask:0xf
    v_perm_b32 v16, v14, v14, v8
    v_perm_b32 v17, v14, v14, v9
    v_perm_b32 v18, v14, v14, v10
    v_perm_b32 v19, v14, v14, v11
    v_mov_b32_dpp v15, v12 row_newbcast:1 row_mask:0xf bank_mask:0xf
    v_perm_b32 v20, v15, v15, v8
    v_perm_b32 v21, v15, v15, v9
    v_perm_b32 v22, v15, v15, v10
    v_perm_b32 v23, v15, v15, v11
    s_waitcnt vmcnt(31)
    v_mfma_f32_16x16x32_bf16 v[24:27], v[16:19], v[32:35], 0
    v_mov_b32_dpp v14, v12 row_newbcast:2 row_mask:0xf bank_mask:0xf
    v_perm_b32 v16, v14, v14, v8
    v_perm_b32 v17, v14, v14, v9
    v_perm_b32 v18, v14, v14, v10
    v_perm_b32 v19, v14, v14, v11
    s_waitcnt vmcnt(30)
    v_mfma_f32_16x16x32_bf16 v[24:27], v[20:23], v[36:39], v[24:27]
    v_mov_b32_dpp v15, v12 row_newbcast:3 row_mask:0xf bank_mask:0xf
    v_perm_b32 v20, v15, v15, v8
    v_perm_b32 v21, v15, v15, v9
    v_perm_b32 v22, v15, v15, v10
    v_perm_b32 v23, v15, v15, v11
    s_waitcnt vmcnt(29)
    v_mfma_f32_16x16x32_bf16 v[24:27], v[16:19], v[40:43], v[24:27]
    v_mov_b32_dpp v14, v12 row_newbcast:4 row_mask:0xf bank_mask:0xf
    v_perm_b32 v16, v14, v14, v8
    v_perm_b32 v17, v14, v14, v9
    v_perm_b32 v18, v14, v14, v10
    v_perm_b32 v19, v14, v14, v11
    s_waitcnt vmcnt(28)
    v_mfma_f32_16x16x32_bf16 v[24:27], v[20:23], v[44:47], v[24:27]
    v_mov_b32_dpp v15, v12 row_newbcast:5 row_mask:0xf bank_mask:0xf
    v_perm_b32 v20, v15, v15, v8
    v_perm_b32 v21, v15, v15, v9
    v_perm_b32 v22, v15, v15, v10
    v_perm_b32 v23, v15, v15, v11
    s_waitcnt vmcnt(27)
    v_mfma_f32_16x16x32_bf16 v[24:27], v[16:19], v[48:51], v[24:27]
    v_mov_b32_dpp v14, v12 row_newbcast:6 row_mask:0xf bank_mask:0xf
    v_perm_b32 v16, v14, v14, v8
    v_perm_b32 v17, v14, v14, v9
    v_perm_b32 v18, v14, v14, v10
    v_perm_b32 v19, v14, v14, v11
    s_waitcnt vmcnt(26)
    v_mfma_f32_16x16x32_bf16 v[24:27], v[20:23], v[52:55], v[24:27]
    v_mov_b32_dpp v15, v12 row_newbcast:7 row_mask:0xf bank_mask:0xf
    v_perm_b32 v20, v15, v15, v8
    v_perm_b32 v21, v15, v15, v9
    v_perm_b32 v22, v15, v15, v10
    v_perm_b32 v23, v15, v15, v11
    s_waitcnt vmcnt(25)
    v_mfma_f32_16x16x32_bf16 v[24:27], v[16:19], v[56:59], v[24:27]
    v_mov_b32_dpp v14, v12 row_newbcast:8 row_mask:0xf bank_mask:0xf
    v_perm_b32 v16, v14, v14, v8
    v_perm_b32 v17, v14, v14, v9
    v_perm_b32 v18, v14, v14, v10
    v_perm_b32 v19, v14, v14, v11
    s_waitcnt vmcnt(24)
    v_mfma_f32_16x16x32_bf16 v[24:27], v[20:23], v[60:63], v[24:27]
    v_mov_b32_dpp v15, v12 row_newbcast:9 row_mask:0xf bank_mask:0xf
    v_perm_b32 v20, v15, v15, v8
    v_perm_b32 v21, v15, v15, v9
    v_perm_b32 v22, v15, v15, v10
    v_perm_b32 v23, v15, v15, v11
    s_waitcnt vmcnt(23)
    v_mfma_f32_16x16x32_bf16 v[24:27], v[16:19], v[64:67], v[24:27]
    v_mov_b32_dpp v14, v12 row_newbcast:10 row_mask:0xf bank_mask:0xf
    v_perm_b32 v16, v14, v14, v8
    v_perm_b32 v17, v14, v14, v9
    v_perm_b32 v18, v14, v14, v10
    v_perm_b32 v19, v14, v14, v11
    s_waitcnt vmcnt(22)
    v_mfma_f32_16x16x32_bf16 v[24:27], v[20:23], v[68:71], v[24:27]
    v_mov_b32_dpp v15, v12 row_newbcast:11 row_mask:0xf bank_mask:0xf
    v_perm_b32 v20, v15, v15, v8
    v_perm_b32 v21, v15, v15, v9
    v_perm_b32 v22, v15, v15, v10
    v_perm_b32 v23, v15, v15, v11
    s_waitcnt vmcnt(21)
    v_mfma_f32_16x16x32_bf16 v[24:27], v[16:19], v[72:75], v[24:27]
    v_mov_b32_dpp v14, v12 row_newbcast:12 row_mask:0xf bank_mask:0xf
    v_perm_b32 v16, v14, v14, v8
    v_perm_b32 v17, v14, v14, v9
    v_perm_b32 v18, v14, v14, v10
    v_perm_b32 v19, v14, v14, v11
    s_waitcnt vmcnt(20)
    v_mfma_f32_16x16x32_bf16 v[24:27], v[20:23], v[76:79], v[24:27]
    v_mov_b32_dpp v15, v12 row_newbcast:13 row_mask:0xf bank_mask:0xf
    v_perm_b32 v20, v15, v15, v8
    v_perm_b32 v21, v15, v15, v9
    v_perm_b32 v22, v15, v15, v10
    v_perm_b32 v23, v15, v15, v11
    s_waitcnt vmcnt(19)
    v_mfma_f32_16x16x32_bf16 v[24:27], v[16:19], v[80:83], v[24:27]
    v_mov_b32_dpp v14, v12 row_newbcast:14 row_mask:0xf bank_mask:0xf
    v_perm_b32 v16, v14, v14, v8
    v_perm_b32 v17, v14, v14, v9
    v_perm_b32 v18, v14, v14, v10
    v_perm_b32 v19, v14, v14, v11
    s_waitcnt vmcnt(18)
    v_mfma_f32_16x16x32_bf16 v[24:27], v[20:23], v[84:87], v[24:27]
    v_mov_b32_dpp v15, v12 row_newbcast:15 row_mask:0xf bank_mask:0xf
    v_perm_b32 v20, v15, v15, v8
    v_perm_b32 v21, v15, v15, v9
    v_perm_b32 v22, v15, v15, v10
    v_perm_b32 v23, v15, v15, v11
    s_waitcnt vmcnt(17)
    v_mfma_f32_16x16x32_bf16 v[24:27], v[16:19], v[88:91], v[24:27]
    v_mov_b32_dpp v14, v13 row_newbcast:0 row_mask:0xf bank_mask:0xf
    v_perm_b32 v16, v14, v14, v8
    v_perm_b32 v17, v14, v14, v9
    v_perm_b32 v18, v14, v14, v10
    v_perm_b32 v19, v14, v14, v11
    s_waitcnt vmcnt(16)
    v_mfma_f32_16x16x32_bf16 v[24:27], v[20:23], v[92:95], v[24:27]
    v_mov_b32_dpp v15, v13 row_newbcast:1 row_mask:0xf bank_mask:0xf
    v_perm_b32 v20, v15, v15, v8
    v_perm_b32 v21, v15, v15, v9
    v_perm_b32 v22, v15, v15, v10
    v_perm_b32 v23, v15, v15, v11
    s_waitcnt vmcnt(15)
    v_mfma_f32_16x16x32_bf16 v[24:27], v[16:19], v[96:99], v[24:27]
    v_mov_b32_dpp v14, v13 row_newbcast:2 row_mask:0xf bank_mask:0xf
    v_perm_b32 v16, v14, v14, v8
    v_perm_b32 v17, v14, v14, v9
    v_perm_b32 v18, v14, v14, v10
    v_perm_b32 v19, v14, v14, v11
    s_waitcnt vmcnt(14)
    v_mfma_f32_16x16x32_bf16 v[24:27], v[20:23], v[100:103], v[24:27]
    v_mov_b32_dpp v15, v13 row_newbcast:3 row_mask:0xf bank_mask:0xf
    v_perm_b32 v20, v15, v15, v8
    v_perm_b32 v21, v15, v15, v9
    v_perm_b32 v22, v15, v15, v10
    v_perm_b32 v23, v15, v15, v11
    s_waitcnt vmcnt(13)
    v_mfma_f32_16x16x32_bf16 v[24:27], v[16:19], v[104:107], v[24:27]
    v_mov_b32_dpp v14, v13 row_newbcast:4 row_mask:0xf bank_mask:0xf
    v_perm_b32 v16, v14, v14, v8
    v_perm_b32 v17, v14, v14, v9
    v_perm_b32 v18, v14, v14, v10
    v_perm_b32 v19, v14, v14, v11
    s_waitcnt vmcnt(12)
    v_mfma_f32_16x16x32_bf16 v[24:27], v[20:23], v[108:111], v[24:27]
    v_mov_b32_dpp v15, v13 row_newbcast:5 row_mask:0xf bank_mask:0xf
    v_perm_b32 v20, v15, v15, v8
    v_perm_b32 v21, v15, v15, v9
    v_perm_b32 v22, v15, v15, v10
    v_perm_b32 v23, v15, v15, v11
    s_waitcnt vmcnt(11)
    v_mfma_f32_16x16x32_bf16 v[24:27], v[16:19], v[112:115], v[24:27]
    v_mov_b32_dpp v14, v13 row_newbcast:6 row_mask:0xf bank_mask:0xf
    v_perm_b32 v16, v14, v14, v8
    v_perm_b32 v17, v14, v14, v9
    v_perm_b32 v18, v14, v14, v10
    v_perm_b32 v19, v14, v14, v11
    s_waitcnt vmcnt(10)
    v_mfma_f32_16x16x32_bf16 v[24:27], v[20:23], v[116:119], v[24:27]
    v_mov_b32_dpp v15, v13 row_newbcast:7 row_mask:0xf bank_mask:0xf
    v_perm_b32 v20, v15, v15, v8
    v_perm_b32 v21, v15, v15, v9
    v_perm_b32 v22, v15, v15, v10
    v_perm_b32 v23, v15, v15, v11
    s_waitcnt vmcnt(9)
    v_mfma_f32_16x16x32_bf16 v[24:27], v[16:19], v[120:123], v[24:27]
    v_mov_b32_dpp v14, v13 row_newbcast:8 row_mask:0xf bank_mask:0xf
    v_perm_b32 v16, v14, v14, v8
    v_perm_b32 v17, v14, v14, v9
    v_perm_b32 v18, v14, v14, v10
    v_perm_b32 v19, v14, v14, v11
    s_waitcnt vmcnt(8)
    v_mfma_f32_16x16x32_bf16 v[24:27], v[20:23], v[124:127], v[24:27]
    v_mov_b32_dpp v15, v13 row_newbcast:9 row_mask:0xf bank_mask:0xf
    v_perm_b32 v20, v15, v15, v8
    v_perm_b32 v21, v15, v15, v9
    v_perm_b32 v22, v15, v15, v10
    v_perm_b32 v23, v15, v15, v11
    s_waitcnt vmcnt(7)
    v_mfma_f32_16x16x32_bf16 v[24:27], v[16:19], v[128:131], v[24:27]
    v_mov_b32_dpp v14, v13 row_newbcast:10 row_mask:0xf bank_mask:0xf
    v_perm_b32 v16, v14, v14, v8
    v_perm_b32 v17, v14, v14, v9
    v_perm_b32 v18, v14, v14, v10
    v_perm_b32 v19, v14, v14, v11
    s_waitcnt vmcnt(6)
    v_mfma_f32_16x16x32_bf16 v[24:27], v[20:23], v[132:135], v[24:27]
    v_mov_b32_dpp v15, v13 row_newbcast:11 row_mask:0xf bank_mask:0xf
    v_perm_b32 v20, v15, v15, v8
    v_perm_b32 v21, v15, v15, v9
    v_perm_b32 v22, v15, v15, v10
    v_perm_b32 v23, v15, v15, v11
    s_waitcnt vmcnt(5)
    v_mfma_f32_16x16x32_bf16 v[24:27], v[16:19], v[136:139], v[24:27]
    v_mov_b32_dpp v14, v13 row_newbcast:12 row_mask:0xf bank_mask:0xf
    v_perm_b32 v16, v14, v14, v8
    v_perm_b32 v17, v14, v14, v9
    v_perm_b32 v18, v14, v14, v10
    v_perm_b32 v19, v14, v14, v11
    s_waitcnt vmcnt(4)
    v_mfma_f32_16x16x32_bf16 v[24:27], v[20:23], v[140:143], v[24:27]
    v_mov_b32_dpp v15, v13 row_newbcast:13 row_mask:0xf bank_mask:0xf
    v_perm_b32 v20, v15, v15, v8
    v_perm_b32 v21, v15, v15, v9
    v_perm_b32 v22, v15, v15, v10
    v_perm_b32 v23, v15, v15, v11
    s_waitcnt vmcnt(3)
    v_mfma_f32_16x16x32_bf16 v[24:27], v[16:19], v[144:147], v[24:27]
    v_mov_b32_dpp v14, v13 row_newbcast:14 row_mask:0xf bank_mask:0xf
    v_perm_b32 v16, v14, v14, v8
    v_perm_b32 v17, v14, v14, v9
    v_perm_b32 v18, v14, v14, v10
    v_perm_b32 v19, v14, v14, v11
    s_waitcnt vmcnt(2)
    v_mfma_f32_16x16x32_bf16 v[24:27], v[20:23], v[148:151], v[24:27]
    v_mov_b32_dpp v15, v13 row_newbcast:15 row_mask:0xf bank_mask:0xf
    v_perm_b32 v20, v15, v15, v8
    v_perm_b32 v21, v15, v15, v9
    v_perm_b32 v22, v15, v15, v10
    v_perm_b32 v23, v15, v15, v11
    s_waitcnt vmcnt(1)
    v_mfma_f32_16x16x32_bf16 v[24:27], v[16:19], v[152:155], v[24:27]
    s_nop 1
    s_waitcnt vmcnt(0)
    v_mfma_f32_16x16x32_bf16 v[24:27], v[20:23], v[156:159], v[24:27]
    s_nop 7
    v_permlane32_swap_b32 v24, v26
    v_permlane32_swap_b32 v25, v27
    s_nop 0
    v_add_f32 v24, v24, v26
    v_add_f32 v25, v25, v27
    ds_write_b64 v5, v[24:25]
    s_waitcnt lgkmcnt(0)
    s_barrier
    s_cmp_eq_u32 s38, 0
    s_cbranch_scc1 L_final
    s_endpgm
L_final:
    ds_read_b64 v[34:35], v5 offset:512
    ds_read_b64 v[36:37], v5 offset:1024
    ds_read_b64 v[38:39], v5 offset:1536
    s_cmp_eq_u32 s37, 5
    s_cbranch_scc1 L_consumer
    s_lshl_b32 s54, s36, 13
    v_lshlrev_b32 v5, 4, v1
    s_lshl_b32 s40, s37, 10
    s_add_u32 s54, s54, s40
    s_add_u32 s41, s54, 1048576
    v_mov_b32 v50, s48
    v_mov_b32 v51, s49
    s_waitcnt lgkmcnt(0)
    v_pk_add_f32 v[24:25], v[24:25], v[34:35]
    v_pk_add_f32 v[36:37], v[36:37], v[38:39]
    v_pk_add_f32 v[48:49], v[24:25], v[36:37]
    buffer_store_dwordx4 v[48:51], v5, s[32:35], s41 offen sc1
    s_endpgm
L_consumer:
    v_lshlrev_b32 v5, 3, v1
    v_add_u32 v5, 152832, v5
    ds_read_b64 v[40:41], v5 offset:0
    ds_read_b64 v[42:43], v5 offset:512
    ds_read_b64 v[44:45], v5 offset:1024
    ds_read_b64 v[46:47], v5 offset:1536
    ds_read_b64 v[48:49], v5 offset:2048
    ds_read_b64 v[50:51], v5 offset:2560
    ds_read_b64 v[52:53], v5 offset:3072
    v_mov_b32 v162, 149560
    ds_read_b32 v163, v162
    v_and_b32 v5, 1, v3
    v_lshlrev_b32 v5, 1, v5
    v_lshrrev_b32 v161, 1, v3
    v_add_u32 v5, v5, v161
    v_lshl_add_u32 v5, v2, 2, v5
    v_lshlrev_b32 v5, 2, v5
    s_waitcnt lgkmcnt(0)
    v_pk_add_f32 v[24:25], v[24:25], v[34:35]
    v_pk_add_f32 v[36:37], v[36:37], v[38:39]
    v_pk_add_f32 v[40:41], v[40:41], v[42:43]
    v_pk_add_f32 v[44:45], v[44:45], v[46:47]
    v_pk_add_f32 v[48:49], v[48:49], v[50:51]
    v_pk_add_f32 v[24:25], v[24:25], v[52:53]
    v_pk_add_f32 v[36:37], v[36:37], v[40:41]
    v_pk_add_f32 v[44:45], v[44:45], v[48:49]
    v_pk_add_f32 v[24:25], v[24:25], v[36:37]
    v_pk_add_f32 v[24:25], v[24:25], v[44:45]
    v_cvt_pk_bf16_f32 v160, v24, v25
    v_lshlrev_b32 v24, 16, v160
    v_and_b32 v25, s46, v160
    v_mul_f32 v24, v24, v163
    v_mul_f32 v25, v25, v163
    v_cvt_pk_bf16_f32 v160, v24, v25
    buffer_store_dword v160, v5, s[24:27], s47 offen
L_end:
    s_endpgm
.section .rodata,"a"
.p2align 6
.amdhsa_kernel standalone__linear_kernel_rfa__decode_kernel
  .amdhsa_next_free_vgpr 168
  .amdhsa_next_free_sgpr 64
  .amdhsa_accum_offset 168
  .amdhsa_group_segment_fixed_size 0
  .amdhsa_kernarg_size 56
  .amdhsa_user_sgpr_count 2
  .amdhsa_user_sgpr_kernarg_segment_ptr 1
  .amdhsa_system_sgpr_workgroup_id_x 1
.end_amdhsa_kernel
```
